```python
import torch

def _softmax(x, axis=-1):
    return torch.softmax(x, dim=axis)
def _gelu(x):
    return torch.nn.functional.gelu(x, approximate="tanh")
def _silu(x):
    return torch.nn.functional.silu(x)
def _sigmoid(x):
    return torch.sigmoid(x)
def _layernorm(x, axis=-1, eps=1e-5):
    m = x.mean(dim=axis, keepdim=True)
    v = x.var(dim=axis, keepdim=True, unbiased=False)
    return (x - m) / torch.sqrt(v + eps)
def _scatter_add(tgt, idx, src, axis=0):
    return tgt.clone().index_add_(axis, idx, src)
def _segment_sum(src, seg, n):
    out = torch.zeros((n,) + src.shape[1:], dtype=src.dtype)
    return out.index_add_(0, seg, src)
def _pad(x, pw):
    flat = tuple(v for pair in reversed(pw) for v in pair)
    return torch.nn.functional.pad(x, flat)

kernel_name = 'standalone__mha_softmax__decode'

def setup_inputs():

    _w = (lambda a: (lambda t: t.to(torch.bfloat16) if t.is_floating_point() else t)(torch.as_tensor(a)))
    B, H, Sq, Sk, D = 1, 32, 1, 32768, 192
    return {
        "q": _w((lambda *s: torch.randn(*s, dtype=torch.bfloat16) * 0.8)(B, H, Sq, D)),
        "k": _w((lambda *s: torch.randn(*s, dtype=torch.bfloat16) * 0.8)(B, H, Sk, D)),
        "v": _w((lambda *s: torch.randn(*s, dtype=torch.bfloat16) * 0.05)(B, H, Sk, D)),
    }

def reference(q, k, v):
    scale = q.shape[-1] ** -0.5
    scores = torch.einsum("bhqd,bhkd->bhqk", q, k) * scale
    p = _softmax(scores, axis=-1)
    return torch.einsum("bhqk,bhkd->bhqd", p, v)
```

```asm
; @launch grid=(256,1,1) block=(320,1,1) lds=38912
.amdgcn_target "amdgcn-amd-amdhsa--gfx950"
.text
.globl standalone__mha_softmax__decode_kernel
.p2align 8
.type standalone__mha_softmax__decode_kernel,@function
standalone__mha_softmax__decode_kernel:
    s_cmp_ge_u32 s2, 256
    s_cbranch_scc1 L_done
    s_load_dwordx4 s[4:7], s[0:1], 0
    s_load_dwordx4 s[8:11], s[0:1], 16
    s_load_dwordx4 s[12:15], s[0:1], 32
    v_lshrrev_b32 v3, 6, v0
    v_and_b32 v0, 63, v0
    v_readfirstlane_b32 s26, v3
    s_lshr_b32 s24, s2, 6
    s_and_b32 s25, s2, 63
    s_mul_i32 s56, s25, 4
    s_cmp_eq_u32 s26, 4
    s_cbranch_scc1 L_service
    v_lshrrev_b32 v59, 3, v0
    v_and_b32 v55, 7, v0
    v_lshlrev_b32 v55, 4, v55
    v_mul_u32_u24 v6, 384, v59
    v_add_u32 v1, v6, v55
    s_mov_b32 s18, 402653184
    s_mov_b32 s19, 0x00020000
    s_mov_b32 s22, 402653184
    s_mov_b32 s23, 0x00020000
    s_mul_i32 s33, s24, 12582912
    s_add_u32 s34, s56, s26
    s_mul_i32 s32, s34, 6144
    s_add_u32 s32, s32, s33
    s_add_u32 s57, s32, 3072
    s_mul_i32 s29, s24, 384
    v_add_u32 v7, s29, v55
    s_waitcnt lgkmcnt(0)
    global_load_dwordx4 v[14:17], v7, s[4:5] offset:0
    global_load_dwordx4 v[18:21], v7, s[4:5] offset:128
    global_load_dwordx4 v[22:25], v7, s[4:5] offset:256
    s_and_b32 s7, s7, 0xffff
    s_and_b32 s9, s9, 0xffff
    s_mov_b64 s[16:17], s[6:7]
    s_mov_b64 s[20:21], s[6:7]
    buffer_load_dwordx4 v[60:63], v1, s[16:19], s32 offen offset:0 nt
    buffer_load_dwordx4 v[64:67], v1, s[16:19], s32 offen offset:128 nt
    buffer_load_dwordx4 v[68:71], v1, s[16:19], s32 offen offset:256 nt
    buffer_load_dwordx4 v[72:75], v1, s[20:23], s57 offen offset:0 nt
    buffer_load_dwordx4 v[76:79], v1, s[20:23], s57 offen offset:128 nt
    buffer_load_dwordx4 v[80:83], v1, s[20:23], s57 offen offset:256 nt
    s_mov_b32 s27, 0xffff0000
    s_mov_b32 s28, 0x3dd53b95
    s_mov_b32 s30, 0
    v_mov_b32 v27, 0
    s_lshl_b32 s31, s26, 2
    s_add_u32 s31, s31, 3952
    v_mov_b32 v26, s31
    s_mov_b32 s38, 4096
    s_lshl_b32 s31, s26, 10
    s_add_u32 s31, s31, 4096
    v_lshlrev_b32 v54, 4, v0
    v_add_u32 v54, s31, v54
    s_lshl_b32 s63, s26, 2
    s_add_u32 s63, s63, 3968
    s_mul_i32 s31, s26, 4864
    s_add_u32 s31, s31, 19456
    v_lshlrev_b32 v59, 3, v59
    v_add_u32 v59, s31, v59
    v_mov_b32 v53, 0
    v_mov_b32 v28, 0
    v_mov_b32 v29, 0
    v_mov_b32 v30, 0
    v_mov_b32 v31, 0
    v_mov_b32 v32, 0
    v_mov_b32 v33, 0
    v_mov_b32 v34, 0
    v_mov_b32 v35, 0
    v_mov_b32 v36, 0
    v_mov_b32 v37, 0
    v_mov_b32 v38, 0
    v_mov_b32 v39, 0
    v_mov_b32 v40, 0
    v_mov_b32 v41, 0
    v_mov_b32 v42, 0
    v_mov_b32 v43, 0
    v_mov_b32 v44, 0
    v_mov_b32 v45, 0
    v_mov_b32 v46, 0
    v_mov_b32 v47, 0
    v_mov_b32 v48, 0
    v_mov_b32 v49, 0
    v_mov_b32 v50, 0
    v_mov_b32 v51, 0
    s_barrier
L_kround:
    s_cmp_eq_u32 s30, 7
    s_cselect_b32 s58, 640, 0
    s_cselect_b32 s31, 40, 0
    s_sub_u32 s58, 2048, s58
    s_add_u32 s31, s31, 3216
    v_mov_b32 v58, s31
    s_mul_i32 s31, s30, 576
    v_add_u32 v57, s31, v59
    ds_read_b32 v86, v58 offset:4
    v_add_u32 v58, 4, v58
    v_mov_b32 v2, 0xff7fffff
    v_mov_b32 v52, v57
    v_add_u32 v57, 64, v57
    s_waitcnt lgkmcnt(0)
L_k:
    s_cmp_lt_u32 s34, s58
    s_cselect_b32 s35, 0, 0xff800000
    s_waitcnt lgkmcnt(2)
    v_readfirstlane_b32 s36, v86
    s_cmp_eq_u32 s36, -1
    s_cbranch_scc1 L_kw
L_kok:
    s_cmp_lt_u32 s36, s58
    s_cbranch_scc0 L_klast
    s_add_u32 s34, s36, s26
    s_mul_i32 s32, s34, 6144
    s_add_u32 s32, s32, s33
    s_cmp_lt_u32 s34, s58
    s_cselect_b32 s32, s32, 0xf0000000
    s_add_u32 s57, s32, 3072
L_kgo:
    s_waitcnt vmcnt(5)
    v_dot2_f32_bf16 v4, v60, v14, 0
    v_dot2_f32_bf16 v6, v61, v15, 0
    v_dot2_f32_bf16 v4, v62, v16, v4
    v_dot2_f32_bf16 v6, v63, v17, v6
    buffer_load_dwordx4 v[60:63], v1, s[16:19], s32 offen offset:0 nt
    s_waitcnt vmcnt(4)
    v_dot2_f32_bf16 v4, v64, v18, v4
    v_dot2_f32_bf16 v6, v65, v19, v6
    v_dot2_f32_bf16 v4, v66, v20, v4
    v_dot2_f32_bf16 v6, v67, v21, v6
    buffer_load_dwordx4 v[64:67], v1, s[16:19], s32 offen offset:128 nt
    s_waitcnt vmcnt(5)
    v_dot2_f32_bf16 v4, v68, v22, v4
    v_dot2_f32_bf16 v6, v69, v23, v6
    v_dot2_f32_bf16 v4, v70, v24, v4
    v_dot2_f32_bf16 v6, v71, v25, v6
    buffer_load_dwordx4 v[68:71], v1, s[16:19], s32 offen offset:256 nt
    ds_read_b32 v86, v58 offset:4
    v_add_u32 v58, 4, v58
    ds_write_b32 v26, v27
    v_add_u32 v27, 1, v27
    s_waitcnt vmcnt(4)
    v_dot2_f32_bf16 v5, v72, v14, 0
    v_dot2_f32_bf16 v7, v73, v15, 0
    v_dot2_f32_bf16 v5, v74, v16, v5
    v_dot2_f32_bf16 v7, v75, v17, v7
    buffer_load_dwordx4 v[72:75], v1, s[20:23], s57 offen offset:0 nt
    s_waitcnt vmcnt(5)
    v_dot2_f32_bf16 v5, v76, v18, v5
    v_dot2_f32_bf16 v7, v77, v19, v7
    v_dot2_f32_bf16 v5, v78, v20, v5
    v_dot2_f32_bf16 v7, v79, v21, v7
    buffer_load_dwordx4 v[76:79], v1, s[20:23], s57 offen offset:128 nt
    s_waitcnt vmcnt(4)
    v_dot2_f32_bf16 v5, v80, v22, v5
    v_dot2_f32_bf16 v7, v81, v23, v7
    v_dot2_f32_bf16 v5, v82, v24, v5
    v_dot2_f32_bf16 v7, v83, v25, v7
    buffer_load_dwordx4 v[80:83], v1, s[20:23], s57 offen offset:256 nt
    v_add_f32 v4, v4, v6
    s_nop 0
    v_add_f32 v5, v5, v7
    s_nop 0
    v_add_f32_dpp v4, v4, v4 quad_perm:[1,0,3,2] row_mask:0xf bank_mask:0xf
    v_add_f32_dpp v5, v5, v5 quad_perm:[1,0,3,2] row_mask:0xf bank_mask:0xf
    s_nop 0
    v_add_f32_dpp v4, v4, v4 quad_perm:[2,3,0,1] row_mask:0xf bank_mask:0xf
    v_add_f32_dpp v5, v5, v5 quad_perm:[2,3,0,1] row_mask:0xf bank_mask:0xf
    s_nop 0
    v_add_f32_dpp v4, v4, v4 row_half_mirror row_mask:0xf bank_mask:0xf
    v_add_f32_dpp v5, v5, v5 row_half_mirror row_mask:0xf bank_mask:0xf
    v_add_f32 v4, s35, v4
    v_add_f32 v5, s35, v5
    v_max3_f32 v2, v2, v4, v5
    ds_write_b64 v57, v[4:5]
    v_add_u32 v57, 64, v57
    s_cmp_lt_u32 s36, s58
    s_cbranch_scc1 L_k
    ds_write_b32 v52, v2
    s_cmp_eq_u32 s30, 7
    s_cbranch_scc1 L_vstart
    s_cmp_lg_u32 s30, 0
    s_cbranch_scc1 L_qok
    s_barrier
L_qok:
    v_add_u32 v55, 384, v55
    s_add_u32 s30, s30, 1
    s_add_u32 s33, s33, 50331648
    ds_read_b128 v[14:17], v55 offset:0
    ds_read_b128 v[18:21], v55 offset:128
    ds_read_b128 v[22:25], v55 offset:256
    s_branch L_kround
L_vstart:
    s_mov_b32 s30, 0
    s_sub_u32 s33, s33, 352321536
L_vround:
    s_cmp_eq_u32 s30, 7
    s_cselect_b32 s58, 640, 0
    s_cselect_b32 s31, 40, 0
    s_sub_u32 s58, 2048, s58
    s_add_u32 s31, s31, 3216
    v_mov_b32 v58, s31
    s_mul_i32 s31, s30, 576
    v_add_u32 v57, s31, v59
    ds_read_b32 v2, v57
    v_add_u32 v57, 64, v57
    ds_read_b64 v[84:85], v57
    ds_read_b32 v86, v58 offset:4
    v_add_u32 v58, 4, v58
    s_waitcnt lgkmcnt(0)
    v_mul_f32 v52, s28, v2
L_v:
    s_waitcnt lgkmcnt(1)
    v_readfirstlane_b32 s36, v86
    v_fma_f32 v4, v84, s28, -v52
    v_fma_f32 v5, v85, s28, -v52
    s_cmp_lt_u32 s36, s58
    s_cbranch_scc0 L_vlast
    s_add_u32 s34, s36, s26
    s_mul_i32 s32, s34, 6144
    s_add_u32 s32, s32, s33
    s_cmp_lt_u32 s34, s58
    s_cselect_b32 s32, s32, 0xf0000000
    s_add_u32 s57, s32, 3072
L_vgo:
    v_exp_f32 v4, v4
    v_exp_f32 v5, v5
    s_nop 0
    v_add_f32 v53, v53, v4
    v_add_f32 v53, v53, v5
    s_waitcnt vmcnt(5)
    v_lshlrev_b32 v6, 16, v60
    v_and_b32 v7, s27, v60
    v_lshlrev_b32 v8, 16, v61
    v_and_b32 v9, s27, v61
    v_lshlrev_b32 v10, 16, v62
    v_and_b32 v11, s27, v62
    v_lshlrev_b32 v12, 16, v63
    v_and_b32 v13, s27, v63
    buffer_load_dwordx4 v[60:63], v1, s[16:19], s32 offen offset:0 nt
    v_pk_fma_f32 v[28:29], v[6:7], v[4:5], v[28:29] op_sel:[0,0,0] op_sel_hi:[1,0,1]
    v_pk_fma_f32 v[30:31], v[8:9], v[4:5], v[30:31] op_sel:[0,0,0] op_sel_hi:[1,0,1]
    v_pk_fma_f32 v[32:33], v[10:11], v[4:5], v[32:33] op_sel:[0,0,0] op_sel_hi:[1,0,1]
    v_pk_fma_f32 v[34:35], v[12:13], v[4:5], v[34:35] op_sel:[0,0,0] op_sel_hi:[1,0,1]
    s_waitcnt vmcnt(5)
    v_lshlrev_b32 v6, 16, v64
    v_and_b32 v7, s27, v64
    v_lshlrev_b32 v8, 16, v65
    v_and_b32 v9, s27, v65
    v_lshlrev_b32 v10, 16, v66
    v_and_b32 v11, s27, v66
    v_lshlrev_b32 v12, 16, v67
    v_and_b32 v13, s27, v67
    buffer_load_dwordx4 v[64:67], v1, s[16:19], s32 offen offset:128 nt
    v_pk_fma_f32 v[36:37], v[6:7], v[4:5], v[36:37] op_sel:[0,0,0] op_sel_hi:[1,0,1]
    v_pk_fma_f32 v[38:39], v[8:9], v[4:5], v[38:39] op_sel:[0,0,0] op_sel_hi:[1,0,1]
    v_pk_fma_f32 v[40:41], v[10:11], v[4:5], v[40:41] op_sel:[0,0,0] op_sel_hi:[1,0,1]
    v_pk_fma_f32 v[42:43], v[12:13], v[4:5], v[42:43] op_sel:[0,0,0] op_sel_hi:[1,0,1]
    s_waitcnt vmcnt(4)
    v_lshlrev_b32 v6, 16, v68
    v_and_b32 v7, s27, v68
    v_lshlrev_b32 v8, 16, v69
    v_and_b32 v9, s27, v69
    v_lshlrev_b32 v10, 16, v70
    v_and_b32 v11, s27, v70
    v_lshlrev_b32 v12, 16, v71
    v_and_b32 v13, s27, v71
    buffer_load_dwordx4 v[68:71], v1, s[16:19], s32 offen offset:256 nt
    v_pk_fma_f32 v[44:45], v[6:7], v[4:5], v[44:45] op_sel:[0,0,0] op_sel_hi:[1,0,1]
    v_pk_fma_f32 v[46:47], v[8:9], v[4:5], v[46:47] op_sel:[0,0,0] op_sel_hi:[1,0,1]
    v_pk_fma_f32 v[48:49], v[10:11], v[4:5], v[48:49] op_sel:[0,0,0] op_sel_hi:[1,0,1]
    v_pk_fma_f32 v[50:51], v[12:13], v[4:5], v[50:51] op_sel:[0,0,0] op_sel_hi:[1,0,1]
    ds_read_b64 v[84:85], v57 offset:64
    v_add_u32 v57, 64, v57
    ds_read_b32 v86, v58 offset:4
    v_add_u32 v58, 4, v58
    ds_write_b32 v26, v27
    v_add_u32 v27, 1, v27
    s_waitcnt vmcnt(5)
    v_lshlrev_b32 v6, 16, v72
    v_and_b32 v7, s27, v72
    v_lshlrev_b32 v8, 16, v73
    v_and_b32 v9, s27, v73
    v_lshlrev_b32 v10, 16, v74
    v_and_b32 v11, s27, v74
    v_lshlrev_b32 v12, 16, v75
    v_and_b32 v13, s27, v75
    buffer_load_dwordx4 v[72:75], v1, s[20:23], s57 offen offset:0 nt
    v_pk_fma_f32 v[28:29], v[6:7], v[4:5], v[28:29] op_sel:[0,1,0] op_sel_hi:[1,1,1]
    v_pk_fma_f32 v[30:31], v[8:9], v[4:5], v[30:31] op_sel:[0,1,0] op_sel_hi:[1,1,1]
    v_pk_fma_f32 v[32:33], v[10:11], v[4:5], v[32:33] op_sel:[0,1,0] op_sel_hi:[1,1,1]
    v_pk_fma_f32 v[34:35], v[12:13], v[4:5], v[34:35] op_sel:[0,1,0] op_sel_hi:[1,1,1]
    s_waitcnt vmcnt(5)
    v_lshlrev_b32 v6, 16, v76
    v_and_b32 v7, s27, v76
    v_lshlrev_b32 v8, 16, v77
    v_and_b32 v9, s27, v77
    v_lshlrev_b32 v10, 16, v78
    v_and_b32 v11, s27, v78
    v_lshlrev_b32 v12, 16, v79
    v_and_b32 v13, s27, v79
    buffer_load_dwordx4 v[76:79], v1, s[20:23], s57 offen offset:128 nt
    v_pk_fma_f32 v[36:37], v[6:7], v[4:5], v[36:37] op_sel:[0,1,0] op_sel_hi:[1,1,1]
    v_pk_fma_f32 v[38:39], v[8:9], v[4:5], v[38:39] op_sel:[0,1,0] op_sel_hi:[1,1,1]
    v_pk_fma_f32 v[40:41], v[10:11], v[4:5], v[40:41] op_sel:[0,1,0] op_sel_hi:[1,1,1]
    v_pk_fma_f32 v[42:43], v[12:13], v[4:5], v[42:43] op_sel:[0,1,0] op_sel_hi:[1,1,1]
    s_waitcnt vmcnt(5)
    v_lshlrev_b32 v6, 16, v80
    v_and_b32 v7, s27, v80
    v_lshlrev_b32 v8, 16, v81
    v_and_b32 v9, s27, v81
    v_lshlrev_b32 v10, 16, v82
    v_and_b32 v11, s27, v82
    v_lshlrev_b32 v12, 16, v83
    v_and_b32 v13, s27, v83
    buffer_load_dwordx4 v[80:83], v1, s[20:23], s57 offen offset:256 nt
    v_pk_fma_f32 v[44:45], v[6:7], v[4:5], v[44:45] op_sel:[0,1,0] op_sel_hi:[1,1,1]
    v_pk_fma_f32 v[46:47], v[8:9], v[4:5], v[46:47] op_sel:[0,1,0] op_sel_hi:[1,1,1]
    v_pk_fma_f32 v[48:49], v[10:11], v[4:5], v[48:49] op_sel:[0,1,0] op_sel_hi:[1,1,1]
    v_pk_fma_f32 v[50:51], v[12:13], v[4:5], v[50:51] op_sel:[0,1,0] op_sel_hi:[1,1,1]
    s_cmp_lt_u32 s36, s58
    s_cbranch_scc1 L_v
    s_cmp_lg_u32 s30, 7
    s_cbranch_scc1 L_dump
    s_cmp_ge_u32 s36, 4096
    s_cbranch_scc1 L_dump
L_t:
    s_cmp_lt_u32 s34, 4096
    s_cselect_b32 s35, 0, 0xff800000
    s_waitcnt lgkmcnt(1)
    v_readfirstlane_b32 s36, v86
    s_cmp_eq_u32 s36, -1
    s_cbranch_scc1 L_tw
L_tok:
    s_add_u32 s34, s36, s26
    s_mul_i32 s32, s34, 3072
    s_add_u32 s32, s32, s33
    s_cmp_lt_u32 s34, 4096
    s_cselect_b32 s32, s32, 0xf0000000
    s_mov_b32 s57, s32
    s_waitcnt vmcnt(5)
    v_dot2_f32_bf16 v4, v60, v14, 0
    v_dot2_f32_bf16 v6, v61, v15, 0
    v_dot2_f32_bf16 v4, v62, v16, v4
    v_dot2_f32_bf16 v6, v63, v17, v6
    buffer_load_dwordx4 v[60:63], v1, s[16:19], s32 offen offset:0 nt
    s_waitcnt vmcnt(5)
    v_dot2_f32_bf16 v4, v64, v18, v4
    v_dot2_f32_bf16 v6, v65, v19, v6
    v_dot2_f32_bf16 v4, v66, v20, v4
    v_dot2_f32_bf16 v6, v67, v21, v6
    buffer_load_dwordx4 v[64:67], v1, s[16:19], s32 offen offset:128 nt
    s_waitcnt vmcnt(5)
    v_dot2_f32_bf16 v4, v68, v22, v4
    v_dot2_f32_bf16 v6, v69, v23, v6
    v_dot2_f32_bf16 v4, v70, v24, v4
    v_dot2_f32_bf16 v6, v71, v25, v6
    buffer_load_dwordx4 v[68:71], v1, s[16:19], s32 offen offset:256 nt
    ds_read_b32 v86, v58 offset:4
    v_add_u32 v58, 4, v58
    ds_write_b32 v26, v27
    v_add_u32 v27, 1, v27
    v_add_f32 v4, v4, v6
    s_nop 1
    v_add_f32_dpp v4, v4, v4 quad_perm:[1,0,3,2] row_mask:0xf bank_mask:0xf
    s_nop 1
    v_add_f32_dpp v4, v4, v4 quad_perm:[2,3,0,1] row_mask:0xf bank_mask:0xf
    s_nop 1
    v_add_f32_dpp v4, v4, v4 row_half_mirror row_mask:0xf bank_mask:0xf
    v_add_f32 v4, s35, v4
    v_max_f32 v2, v2, v4
    v_mov_b32 v3, v52
    v_mul_f32 v52, s28, v2
    v_sub_f32 v3, v3, v52
    v_fma_f32 v4, v4, s28, -v52
    v_exp_f32 v3, v3
    v_exp_f32 v4, v4
    v_pk_mul_f32 v[28:29], v[28:29], v[2:3] op_sel:[0,1] op_sel_hi:[1,1]
    v_pk_mul_f32 v[30:31], v[30:31], v[2:3] op_sel:[0,1] op_sel_hi:[1,1]
    v_pk_mul_f32 v[32:33], v[32:33], v[2:3] op_sel:[0,1] op_sel_hi:[1,1]
    v_pk_mul_f32 v[34:35], v[34:35], v[2:3] op_sel:[0,1] op_sel_hi:[1,1]
    v_pk_mul_f32 v[36:37], v[36:37], v[2:3] op_sel:[0,1] op_sel_hi:[1,1]
    v_pk_mul_f32 v[38:39], v[38:39], v[2:3] op_sel:[0,1] op_sel_hi:[1,1]
    v_pk_mul_f32 v[40:41], v[40:41], v[2:3] op_sel:[0,1] op_sel_hi:[1,1]
    v_pk_mul_f32 v[42:43], v[42:43], v[2:3] op_sel:[0,1] op_sel_hi:[1,1]
    v_pk_mul_f32 v[44:45], v[44:45], v[2:3] op_sel:[0,1] op_sel_hi:[1,1]
    v_pk_mul_f32 v[46:47], v[46:47], v[2:3] op_sel:[0,1] op_sel_hi:[1,1]
    v_pk_mul_f32 v[48:49], v[48:49], v[2:3] op_sel:[0,1] op_sel_hi:[1,1]
    v_pk_mul_f32 v[50:51], v[50:51], v[2:3] op_sel:[0,1] op_sel_hi:[1,1]
    v_fma_f32 v53, v53, v3, v4
    s_waitcnt vmcnt(5)
    v_lshlrev_b32 v6, 16, v72
    v_and_b32 v7, s27, v72
    v_lshlrev_b32 v8, 16, v73
    v_and_b32 v9, s27, v73
    v_lshlrev_b32 v10, 16, v74
    v_and_b32 v11, s27, v74
    v_lshlrev_b32 v12, 16, v75
    v_and_b32 v13, s27, v75
    buffer_load_dwordx4 v[72:75], v1, s[20:23], s57 offen offset:0 nt
    v_pk_fma_f32 v[28:29], v[6:7], v[4:5], v[28:29] op_sel:[0,0,0] op_sel_hi:[1,0,1]
    v_pk_fma_f32 v[30:31], v[8:9], v[4:5], v[30:31] op_sel:[0,0,0] op_sel_hi:[1,0,1]
    v_pk_fma_f32 v[32:33], v[10:11], v[4:5], v[32:33] op_sel:[0,0,0] op_sel_hi:[1,0,1]
    v_pk_fma_f32 v[34:35], v[12:13], v[4:5], v[34:35] op_sel:[0,0,0] op_sel_hi:[1,0,1]
    s_waitcnt vmcnt(5)
    v_lshlrev_b32 v6, 16, v76
    v_and_b32 v7, s27, v76
    v_lshlrev_b32 v8, 16, v77
    v_and_b32 v9, s27, v77
    v_lshlrev_b32 v10, 16, v78
    v_and_b32 v11, s27, v78
    v_lshlrev_b32 v12, 16, v79
    v_and_b32 v13, s27, v79
    buffer_load_dwordx4 v[76:79], v1, s[20:23], s57 offen offset:128 nt
    v_pk_fma_f32 v[36:37], v[6:7], v[4:5], v[36:37] op_sel:[0,0,0] op_sel_hi:[1,0,1]
    v_pk_fma_f32 v[38:39], v[8:9], v[4:5], v[38:39] op_sel:[0,0,0] op_sel_hi:[1,0,1]
    v_pk_fma_f32 v[40:41], v[10:11], v[4:5], v[40:41] op_sel:[0,0,0] op_sel_hi:[1,0,1]
    v_pk_fma_f32 v[42:43], v[12:13], v[4:5], v[42:43] op_sel:[0,0,0] op_sel_hi:[1,0,1]
    s_waitcnt vmcnt(5)
    v_lshlrev_b32 v6, 16, v80
    v_and_b32 v7, s27, v80
    v_lshlrev_b32 v8, 16, v81
    v_and_b32 v9, s27, v81
    v_lshlrev_b32 v10, 16, v82
    v_and_b32 v11, s27, v82
    v_lshlrev_b32 v12, 16, v83
    v_and_b32 v13, s27, v83
    buffer_load_dwordx4 v[80:83], v1, s[20:23], s57 offen offset:256 nt
    v_pk_fma_f32 v[44:45], v[6:7], v[4:5], v[44:45] op_sel:[0,0,0] op_sel_hi:[1,0,1]
    v_pk_fma_f32 v[46:47], v[8:9], v[4:5], v[46:47] op_sel:[0,0,0] op_sel_hi:[1,0,1]
    v_pk_fma_f32 v[48:49], v[10:11], v[4:5], v[48:49] op_sel:[0,0,0] op_sel_hi:[1,0,1]
    v_pk_fma_f32 v[50:51], v[12:13], v[4:5], v[50:51] op_sel:[0,0,0] op_sel_hi:[1,0,1]
    s_cmp_lt_u32 s36, 4096
    s_cbranch_scc1 L_t
L_dump:
    v_max_f32_dpp v9, v52, v52 row_ror:8 row_mask:0xf bank_mask:0xf
    v_mov_b32 v12, s63
    v_mov_b32 v10, v9
    s_nop 1
    v_permlane16_swap_b32 v9, v10
    s_nop 0
    v_max_f32 v9, v9, v10
    v_mov_b32 v10, v9
    s_nop 1
    v_permlane32_swap_b32 v9, v10
    s_nop 0
    v_max_f32 v9, v9, v10
    v_sub_f32 v3, v52, v9
    v_exp_f32 v3, v3
    s_xor_b32 s63, s63, 16
    v_mul_f32 v53, v53, v3
    v_pk_mul_f32 v[28:29], v[28:29], v[2:3] op_sel:[0,1] op_sel_hi:[1,1]
    v_pk_mul_f32 v[30:31], v[30:31], v[2:3] op_sel:[0,1] op_sel_hi:[1,1]
    v_pk_mul_f32 v[32:33], v[32:33], v[2:3] op_sel:[0,1] op_sel_hi:[1,1]
    v_pk_mul_f32 v[34:35], v[34:35], v[2:3] op_sel:[0,1] op_sel_hi:[1,1]
    v_pk_mul_f32 v[36:37], v[36:37], v[2:3] op_sel:[0,1] op_sel_hi:[1,1]
    v_pk_mul_f32 v[38:39], v[38:39], v[2:3] op_sel:[0,1] op_sel_hi:[1,1]
    v_pk_mul_f32 v[40:41], v[40:41], v[2:3] op_sel:[0,1] op_sel_hi:[1,1]
    v_pk_mul_f32 v[42:43], v[42:43], v[2:3] op_sel:[0,1] op_sel_hi:[1,1]
    v_pk_mul_f32 v[44:45], v[44:45], v[2:3] op_sel:[0,1] op_sel_hi:[1,1]
    v_pk_mul_f32 v[46:47], v[46:47], v[2:3] op_sel:[0,1] op_sel_hi:[1,1]
    v_pk_mul_f32 v[48:49], v[48:49], v[2:3] op_sel:[0,1] op_sel_hi:[1,1]
    v_pk_mul_f32 v[50:51], v[50:51], v[2:3] op_sel:[0,1] op_sel_hi:[1,1]
    v_add_f32_dpp v11, v53, v53 row_ror:8 row_mask:0xf bank_mask:0xf
    v_permlane32_swap_b32 v28, v32
    v_permlane32_swap_b32 v29, v33
    v_permlane32_swap_b32 v30, v34
    v_permlane32_swap_b32 v31, v35
    v_permlane32_swap_b32 v36, v40
    v_permlane32_swap_b32 v37, v41
    v_permlane32_swap_b32 v38, v42
    v_permlane32_swap_b32 v39, v43
    v_permlane32_swap_b32 v44, v48
    v_permlane32_swap_b32 v45, v49
    v_permlane32_swap_b32 v46, v50
    v_permlane32_swap_b32 v47, v51
    v_mov_b32 v10, v11
    v_add_f32 v28, v28, v32
    v_add_f32 v29, v29, v33
    v_add_f32 v30, v30, v34
    v_add_f32 v31, v31, v35
    v_add_f32 v36, v36, v40
    v_add_f32 v37, v37, v41
    v_add_f32 v38, v38, v42
    v_add_f32 v39, v39, v43
    v_add_f32 v44, v44, v48
    v_add_f32 v45, v45, v49
    v_add_f32 v46, v46, v50
    v_add_f32 v47, v47, v51
    v_permlane16_swap_b32 v11, v10
    v_permlane16_swap_b32 v28, v30
    v_permlane16_swap_b32 v29, v31
    v_permlane16_swap_b32 v36, v38
    v_permlane16_swap_b32 v37, v39
    v_permlane16_swap_b32 v44, v46
    v_permlane16_swap_b32 v45, v47
    v_add_f32 v11, v11, v10
    v_add_f32 v28, v28, v30
    v_add_f32 v29, v29, v31
    v_add_f32 v36, v36, v38
    v_add_f32 v37, v37, v39
    v_add_f32 v44, v44, v46
    v_add_f32 v45, v45, v47
    v_mov_b32 v10, v11
    s_add_u32 s30, s30, 1
    v_add_f32_dpp v6, v28, v28 row_ror:8 row_mask:0xf bank_mask:0x3
    v_add_f32_dpp v7, v36, v36 row_ror:8 row_mask:0xf bank_mask:0x3
    v_add_f32_dpp v8, v44, v44 row_ror:8 row_mask:0xf bank_mask:0x3
    v_permlane32_swap_b32 v11, v10
    v_add_f32_dpp v6, v29, v29 row_ror:8 row_mask:0xf bank_mask:0xc
    v_add_f32_dpp v7, v37, v37 row_ror:8 row_mask:0xf bank_mask:0xc
    v_add_f32_dpp v8, v45, v45 row_ror:8 row_mask:0xf bank_mask:0xc
    v_add_f32 v11, v11, v10
    ds_write_b128 v54, v[6:9]
    ds_write_b32 v12, v11
    v_add_u32 v54, s38, v54
    s_sub_u32 s38, 0, s38
    s_add_u32 s33, s33, 50331648
    s_waitcnt lgkmcnt(0)
    s_barrier
    s_cmp_eq_u32 s30, 8
    s_cbranch_scc1 L_fin
    v_mov_b32 v53, 0
    v_mov_b32 v28, 0
    v_mov_b32 v29, 0
    v_mov_b32 v30, 0
    v_mov_b32 v31, 0
    v_mov_b32 v32, 0
    v_mov_b32 v33, 0
    v_mov_b32 v34, 0
    v_mov_b32 v35, 0
    v_mov_b32 v36, 0
    v_mov_b32 v37, 0
    v_mov_b32 v38, 0
    v_mov_b32 v39, 0
    v_mov_b32 v40, 0
    v_mov_b32 v41, 0
    v_mov_b32 v42, 0
    v_mov_b32 v43, 0
    v_mov_b32 v44, 0
    v_mov_b32 v45, 0
    v_mov_b32 v46, 0
    v_mov_b32 v47, 0
    v_mov_b32 v48, 0
    v_mov_b32 v49, 0
    v_mov_b32 v50, 0
    v_mov_b32 v51, 0
    s_branch L_vround
L_klast:
    s_add_u32 s31, s33, 50331648
    s_cmp_lg_u32 s30, 7
    s_cbranch_scc1 L_klast2
    s_sub_u32 s31, s33, 352321536
    s_mov_b64 s[16:17], s[8:9]
    s_mov_b64 s[20:21], s[8:9]
L_klast2:
    s_add_u32 s34, s56, s26
    s_mul_i32 s32, s34, 6144
    s_add_u32 s32, s32, s31
    s_cmp_lt_u32 s34, s58
    s_cselect_b32 s32, s32, 0xf0000000
    s_add_u32 s57, s32, 3072
    s_branch L_kgo
L_vlast:
    s_cmp_eq_u32 s30, 7
    s_cbranch_scc1 L_vlast2
    s_add_u32 s31, s33, 50331648
    s_add_u32 s34, s56, s26
    s_mul_i32 s32, s34, 6144
    s_add_u32 s32, s32, s31
    s_cmp_lt_u32 s34, s58
    s_cselect_b32 s32, s32, 0xf0000000
    s_add_u32 s57, s32, 3072
    s_branch L_vgo
L_vlast2:
    s_mov_b64 s[16:17], s[6:7]
    v_mov_b32 v58, 3308
    s_mov_b32 s36, -1
L_zw:
    s_mov_b32 s54, 0x100000
L_zw1:
    ds_read_b32 v3, v58
    s_sub_u32 s54, s54, 1
    s_cbranch_scc1 L_zok
    s_waitcnt lgkmcnt(0)
    v_readfirstlane_b32 s36, v3
    s_cmp_eq_u32 s36, -1
    s_cbranch_scc1 L_zw1
    s_branch L_zok
L_zok:
    s_add_u32 s34, s36, s26
    s_mul_i32 s32, s34, 3072
    s_add_u32 s32, s32, s33
    s_cmp_lt_u32 s34, 4096
    s_cselect_b32 s32, s32, 0xf0000000
    s_mov_b32 s57, s32
    s_branch L_vgo
L_kw:
    s_mov_b32 s54, 0x100000
L_kw1:
    ds_read_b32 v3, v58
    s_sub_u32 s54, s54, 1
    s_cbranch_scc1 L_kok
    s_waitcnt lgkmcnt(0)
    v_readfirstlane_b32 s36, v3
    s_cmp_eq_u32 s36, -1
    s_cbranch_scc1 L_kw1
    s_branch L_kok
L_tw:
    s_mov_b32 s54, 0x100000
L_tw1:
    ds_read_b32 v3, v58
    s_sub_u32 s54, s54, 1
    s_cbranch_scc1 L_tok
    s_waitcnt lgkmcnt(0)
    v_readfirstlane_b32 s36, v3
    s_cmp_eq_u32 s36, -1
    s_cbranch_scc1 L_tw1
    s_branch L_tok
L_fin:
    s_cmp_ge_u32 s25, 8
    s_cbranch_scc1 L_done
    s_cmp_ge_u32 s26, 4
    s_cbranch_scc1 L_done
    v_mov_b32 v8, 3072
    ds_read_b32 v8, v8
    s_mul_i32 s37, s25, 4
    s_add_u32 s37, s37, s24
    v_lshlrev_b32 v13, 4, v0
    s_lshl_b32 s31, s37, 10
    s_add_u32 s31, s31, 0x400000
    s_mul_i32 s29, s26, 256
    v_add_u32 v6, s29, v13
    v_and_b32 v6, 1023, v6
    v_add_u32 v6, s31, v6
    s_lshl_b32 s31, s37, 16
    s_mul_i32 s29, s26, 16384
    s_add_u32 s29, s29, s31
    v_add_u32 v9, s29, v13
    v_and_b32 v22, 7, v0
    v_lshlrev_b32 v22, 4, v22
    v_lshrrev_b32 v12, 3, v0
    v_lshl_add_u32 v22, v12, 1, v22
    s_mul_i32 s31, s37, 384
    v_add_u32 v22, s31, v22
    s_lshl_b32 s31, s26, 10
    s_add_u32 s31, s31, 4096
    v_add_u32 v12, s31, v13
    s_waitcnt vmcnt(0) lgkmcnt(0)
    v_readfirstlane_b32 s39, v8
    s_mov_b32 s54, 0x100000
L_poll1:
    s_sub_u32 s54, s54, 1
    s_cbranch_scc1 L_done
    global_load_dwordx4 v[14:17], v6, s[14:15] sc1
    s_waitcnt vmcnt(0)
    v_cmp_eq_u32 vcc, s39, v17
    s_bcnt1_i32_b64 s31, vcc
    s_cmp_lt_u32 s31, 61
    s_cbranch_scc1 L_poll1
L_poll2:
    s_sub_u32 s54, s54, 1
    s_cbranch_scc1 L_done
    v_mov_b32 v7, v9
    global_load_dwordx4 v[14:17], v6, s[14:15] sc1
    global_load_dwordx4 v[60:63], v7, s[14:15] offset:0 sc1
    global_load_dwordx4 v[64:67], v7, s[14:15] offset:1024 sc1
    global_load_dwordx4 v[68:71], v7, s[14:15] offset:2048 sc1
    global_load_dwordx4 v[72:75], v7, s[14:15] offset:3072 sc1
    v_add_u32 v7, 4096, v7
    global_load_dwordx4 v[76:79], v7, s[14:15] offset:0 sc1
    global_load_dwordx4 v[80:83], v7, s[14:15] offset:1024 sc1
    global_load_dwordx4 v[84:87], v7, s[14:15] offset:2048 sc1
    global_load_dwordx4 v[88:91], v7, s[14:15] offset:3072 sc1
    v_add_u32 v7, 4096, v7
    global_load_dwordx4 v[92:95], v7, s[14:15] offset:0 sc1
    global_load_dwordx4 v[96:99], v7, s[14:15] offset:1024 sc1
    global_load_dwordx4 v[100:103], v7, s[14:15] offset:2048 sc1
    global_load_dwordx4 v[104:107], v7, s[14:15] offset:3072 sc1
    v_add_u32 v7, 4096, v7
    global_load_dwordx4 v[108:111], v7, s[14:15] offset:0 sc1
    global_load_dwordx4 v[112:115], v7, s[14:15] offset:1024 sc1
    global_load_dwordx4 v[116:119], v7, s[14:15] offset:2048 sc1
    global_load_dwordx4 v[120:123], v7, s[14:15] offset:3072 sc1
    s_waitcnt vmcnt(16)
    v_cmp_ne_u32 s[80:81], s39, v17
    v_mov_b32 v10, v14
    s_cmp_lg_u64 s[80:81], 0
    s_cbranch_scc1 L_retry
    s_nop 1
    v_max_f32_dpp v10, v10, v10 quad_perm:[1,0,3,2] row_mask:0xf bank_mask:0xf
    s_nop 1
    v_max_f32_dpp v10, v10, v10 quad_perm:[2,3,0,1] row_mask:0xf bank_mask:0xf
    s_nop 1
    v_max_f32_dpp v10, v10, v10 row_half_mirror row_mask:0xf bank_mask:0xf
    s_nop 1
    v_max_f32_dpp v10, v10, v10 row_ror:8 row_mask:0xf bank_mask:0xf
    s_nop 1
    v_mov_b32 v8, v10
    s_nop 1
    v_permlane16_swap_b32 v10, v8
    s_nop 0
    v_max_f32 v10, v10, v8
    v_mov_b32 v8, v10
    s_nop 1
    v_permlane32_swap_b32 v10, v8
    s_nop 0
    v_max_f32 v10, v10, v8
    v_sub_f32 v14, v14, v10
    v_exp_f32 v14, v14
    v_mov_b32 v18, 0
    v_mul_f32 v11, v14, v15
    v_mov_b32 v19, 0
    v_mov_b32 v20, 0
    v_readlane_b32 s64, v14, 0
    v_readlane_b32 s65, v14, 1
    v_add_f32_dpp v11, v11, v11 quad_perm:[1,0,3,2] row_mask:0xf bank_mask:0xf
    v_readlane_b32 s66, v14, 2
    v_readlane_b32 s67, v14, 3
    v_add_f32_dpp v11, v11, v11 quad_perm:[2,3,0,1] row_mask:0xf bank_mask:0xf
    v_readlane_b32 s68, v14, 4
    v_readlane_b32 s69, v14, 5
    v_add_f32_dpp v11, v11, v11 row_half_mirror row_mask:0xf bank_mask:0xf
    v_readlane_b32 s70, v14, 6
    v_readlane_b32 s71, v14, 7
    v_add_f32_dpp v11, v11, v11 row_ror:8 row_mask:0xf bank_mask:0xf
    v_readlane_b32 s72, v14, 8
    v_readlane_b32 s73, v14, 9
    v_readlane_b32 s74, v14, 10
    v_readlane_b32 s75, v14, 11
    v_readlane_b32 s76, v14, 12
    v_readlane_b32 s77, v14, 13
    v_readlane_b32 s78, v14, 14
    v_readlane_b32 s79, v14, 15
    s_waitcnt vmcnt(12)
    v_cmp_ne_u32 vcc, s39, v63
    v_pk_fma_f32 v[18:19], v[60:61], s[64:65], v[18:19] op_sel:[0,0,0] op_sel_hi:[1,0,1]
    v_fma_f32 v20, v62, s64, v20
    v_mov_b32 v8, v11
    s_or_b64 s[80:81], s[80:81], vcc
    v_cmp_ne_u32 vcc, s39, v67
    v_pk_fma_f32 v[18:19], v[64:65], s[64:65], v[18:19] op_sel:[0,1,0] op_sel_hi:[1,1,1]
    v_fma_f32 v20, v66, s65, v20
    v_permlane16_swap_b32 v11, v8
    s_or_b64 s[80:81], s[80:81], vcc
    v_cmp_ne_u32 vcc, s39, v71
    v_pk_fma_f32 v[18:19], v[68:69], s[66:67], v[18:19] op_sel:[0,0,0] op_sel_hi:[1,0,1]
    v_fma_f32 v20, v70, s66, v20
    v_add_f32 v11, v11, v8
    s_or_b64 s[80:81], s[80:81], vcc
    v_cmp_ne_u32 vcc, s39, v75
    v_pk_fma_f32 v[18:19], v[72:73], s[66:67], v[18:19] op_sel:[0,1,0] op_sel_hi:[1,1,1]
    v_fma_f32 v20, v74, s67, v20
    v_mov_b32 v8, v11
    s_or_b64 s[80:81], s[80:81], vcc
    s_waitcnt vmcnt(8)
    v_cmp_ne_u32 vcc, s39, v79
    v_pk_fma_f32 v[18:19], v[76:77], s[68:69], v[18:19] op_sel:[0,0,0] op_sel_hi:[1,0,1]
    v_fma_f32 v20, v78, s68, v20
    v_permlane32_swap_b32 v11, v8
    s_or_b64 s[80:81], s[80:81], vcc
    v_cmp_ne_u32 vcc, s39, v83
    v_pk_fma_f32 v[18:19], v[80:81], s[68:69], v[18:19] op_sel:[0,1,0] op_sel_hi:[1,1,1]
    v_fma_f32 v20, v82, s69, v20
    v_add_f32 v11, v11, v8
    s_or_b64 s[80:81], s[80:81], vcc
    v_cmp_ne_u32 vcc, s39, v87
    v_pk_fma_f32 v[18:19], v[84:85], s[70:71], v[18:19] op_sel:[0,0,0] op_sel_hi:[1,0,1]
    v_fma_f32 v20, v86, s70, v20
    v_rcp_f32 v11, v11
    s_or_b64 s[80:81], s[80:81], vcc
    v_cmp_ne_u32 vcc, s39, v91
    v_pk_fma_f32 v[18:19], v[88:89], s[70:71], v[18:19] op_sel:[0,1,0] op_sel_hi:[1,1,1]
    v_fma_f32 v20, v90, s71, v20
    s_or_b64 s[80:81], s[80:81], vcc
    s_waitcnt vmcnt(4)
    v_cmp_ne_u32 vcc, s39, v95
    v_pk_fma_f32 v[18:19], v[92:93], s[72:73], v[18:19] op_sel:[0,0,0] op_sel_hi:[1,0,1]
    v_fma_f32 v20, v94, s72, v20
    s_or_b64 s[80:81], s[80:81], vcc
    v_cmp_ne_u32 vcc, s39, v99
    v_pk_fma_f32 v[18:19], v[96:97], s[72:73], v[18:19] op_sel:[0,1,0] op_sel_hi:[1,1,1]
    v_fma_f32 v20, v98, s73, v20
    s_or_b64 s[80:81], s[80:81], vcc
    v_cmp_ne_u32 vcc, s39, v103
    v_pk_fma_f32 v[18:19], v[100:101], s[74:75], v[18:19] op_sel:[0,0,0] op_sel_hi:[1,0,1]
    v_fma_f32 v20, v102, s74, v20
    s_or_b64 s[80:81], s[80:81], vcc
    v_cmp_ne_u32 vcc, s39, v107
    v_pk_fma_f32 v[18:19], v[104:105], s[74:75], v[18:19] op_sel:[0,1,0] op_sel_hi:[1,1,1]
    v_fma_f32 v20, v106, s75, v20
    s_or_b64 s[80:81], s[80:81], vcc
    s_waitcnt vmcnt(0)
    v_cmp_ne_u32 vcc, s39, v111
    v_pk_fma_f32 v[18:19], v[108:109], s[76:77], v[18:19] op_sel:[0,0,0] op_sel_hi:[1,0,1]
    v_fma_f32 v20, v110, s76, v20
    s_or_b64 s[80:81], s[80:81], vcc
    v_cmp_ne_u32 vcc, s39, v115
    v_pk_fma_f32 v[18:19], v[112:113], s[76:77], v[18:19] op_sel:[0,1,0] op_sel_hi:[1,1,1]
    v_fma_f32 v20, v114, s77, v20
    s_or_b64 s[80:81], s[80:81], vcc
    v_cmp_ne_u32 vcc, s39, v119
    v_pk_fma_f32 v[18:19], v[116:117], s[78:79], v[18:19] op_sel:[0,0,0] op_sel_hi:[1,0,1]
    v_fma_f32 v20, v118, s78, v20
    s_or_b64 s[80:81], s[80:81], vcc
    v_cmp_ne_u32 vcc, s39, v123
    v_pk_fma_f32 v[18:19], v[120:121], s[78:79], v[18:19] op_sel:[0,1,0] op_sel_hi:[1,1,1]
    v_fma_f32 v20, v122, s79, v20
    s_or_b64 s[80:81], s[80:81], vcc
    s_cbranch_scc1 L_poll2
    ds_write_b128 v12, v[18:21]
    s_waitcnt lgkmcnt(0)
    s_barrier
    s_cmp_lg_u32 s26, 0
    s_cbranch_scc1 L_done
    ds_read_b128 v[64:67], v12 offset:1024
    ds_read_b128 v[68:71], v12 offset:2048
    ds_read_b128 v[72:75], v12 offset:3072
    s_waitcnt lgkmcnt(2)
    v_pk_add_f32 v[18:19], v[18:19], v[64:65]
    v_add_f32 v20, v20, v66
    s_waitcnt lgkmcnt(1)
    v_pk_add_f32 v[18:19], v[18:19], v[68:69]
    v_add_f32 v20, v20, v70
    s_waitcnt lgkmcnt(0)
    v_pk_add_f32 v[18:19], v[18:19], v[72:73]
    v_add_f32 v20, v20, v74
    v_mul_f32 v18, v18, v11
    v_mul_f32 v19, v19, v11
    v_mul_f32 v20, v20, v11
    v_cvt_pk_bf16_f32 v18, v18, v19
    v_cvt_pk_bf16_f32 v20, v20, v20
    global_store_short v22, v18, s[10:11]
    global_store_short_d16_hi v22, v18, s[10:11] offset:128
    global_store_short v22, v20, s[10:11] offset:256
    s_endpgm
L_retry:
    s_waitcnt vmcnt(0)
    s_branch L_poll2
L_service:
    v_lshlrev_b32 v6, 4, v0
    v_mul_u32_u24 v12, 256, v0
    v_add_u32 v12, s56, v12
    v_lshlrev_b32 v13, 2, v0
    s_mov_b32 exec_lo, 0x1ff
    s_mov_b32 exec_hi, 0x0
    ds_write_b32 v13, v12 offset:3216
    s_mov_b64 exec, -1
    v_cmp_gt_u32 vcc, 4, v0
    v_mov_b32 v9, -1
    v_mov_b32 v16, 0
    v_cndmask_b32 v12, -1, v12, vcc
    ds_write_b32 v13, v12 offset:3256
    ds_write_b32 v13, v9 offset:3512
    ds_write_b32 v13, v9 offset:3768
    v_and_b32 v13, 12, v13
    ds_write_b32 v13, v16 offset:3952
    s_mul_i32 s31, s24, 384
    v_add_u32 v7, s31, v6
    s_waitcnt lgkmcnt(0)
    v_mov_b32 v9, 1
    s_barrier
    s_mov_b64 exec, 0xffffff
    v_add_u32 v7, 1536, v7
    global_load_dwordx4 v[64:67], v7, s[4:5]
    v_add_u32 v7, 1536, v7
    global_load_dwordx4 v[68:71], v7, s[4:5]
    v_add_u32 v7, 1536, v7
    global_load_dwordx4 v[72:75], v7, s[4:5]
    v_add_u32 v7, 1536, v7
    global_load_dwordx4 v[76:79], v7, s[4:5]
    v_add_u32 v7, 1536, v7
    global_load_dwordx4 v[80:83], v7, s[4:5]
    v_add_u32 v7, 1536, v7
    global_load_dwordx4 v[84:87], v7, s[4:5]
    v_add_u32 v7, 1536, v7
    global_load_dwordx4 v[88:91], v7, s[4:5]
    s_waitcnt vmcnt(0)
    ds_write_b128 v6, v[64:67] offset:384
    ds_write_b128 v6, v[68:71] offset:768
    ds_write_b128 v6, v[72:75] offset:1152
    ds_write_b128 v6, v[76:79] offset:1536
    ds_write_b128 v6, v[80:83] offset:1920
    ds_write_b128 v6, v[84:87] offset:2304
    ds_write_b128 v6, v[88:91] offset:2688
    s_mov_b64 exec, -1
    s_lshl_b32 s31, s24, 6
    s_add_u32 s31, s31, s25
    s_lshl_b32 s29, s31, 10
    v_add_u32 v7, s29, v6
    s_lshl_b32 s29, s31, 4
    s_add_u32 s29, s29, 0x400000
    v_mul_u32_u24 v8, 4096, v0
    v_add_u32 v8, s29, v8
    s_lshr_b32 s55, s25, 3
    s_and_b32 s55, s55, 1
    s_mul_i32 s31, s24, 2
    s_add_u32 s31, s31, s55
    s_mul_i32 s55, s55, 4
    s_lshl_b32 s31, s31, 8
    s_add_u32 s31, s31, 0x800000
    v_mov_b32 v18, s31
    s_mov_b32 s30, 0
    s_mov_b32 s38, 4096
    v_add_u32 v54, 4096, v6
    v_mov_b32 v28, 3968
    v_add_u32 v17, 12288, v6
    v_mov_b32 v19, 3088
    v_mov_b32 v26, 0
    s_cmp_lg_u32 s2, 0
    s_cbranch_scc1 L_lostA
    s_mov_b64 exec, 1
    global_atomic_add v12, v16, v9, s[12:13] sc0
    s_memrealtime s[50:51]
    s_waitcnt vmcnt(0) lgkmcnt(0)
    v_readfirstlane_b32 s31, v12
    s_mov_b64 exec, -1
    s_cmp_lg_u32 s31, 0
    s_cbranch_scc1 L_lostA
    v_lshlrev_b32 v12, 8, v0
    v_add_u32 v12, 0x800000, v12
    s_or_b32 s50, s50, 1
    v_mov_b32 v13, s50
    global_store_dword v12, v16, s[14:15] sc1
    s_waitcnt vmcnt(0)
    global_store_dword v16, v13, s[12:13] offset:64 sc1
L_lostA:
    s_waitcnt lgkmcnt(0)
    s_barrier
    global_load_dword v12, v16, s[12:13] offset:64 sc1
    s_waitcnt vmcnt(0)
    v_readfirstlane_b32 s39, v12
    s_cmp_lg_u32 s39, 0
    s_cbranch_scc1 L_ready
    s_mov_b64 exec, 1
    global_atomic_add v12, v16, v9, s[12:13] sc0
    s_memrealtime s[50:51]
    s_waitcnt vmcnt(0) lgkmcnt(0)
    v_readfirstlane_b32 s31, v12
    s_mov_b64 exec, -1
    s_cmp_lg_u32 s31, 0
    s_cbranch_scc1 L_lostB
    v_lshlrev_b32 v12, 8, v0
    v_add_u32 v12, 0x800000, v12
    s_or_b32 s50, s50, 1
    v_mov_b32 v13, s50
    global_store_dword v12, v16, s[14:15] sc1
    s_waitcnt vmcnt(0)
    global_store_dword v16, v13, s[12:13] offset:64 sc1
L_lostB:
    s_mov_b32 s54, 0x100000
L_spinf:
    s_sub_u32 s54, s54, 1
    s_cbranch_scc1 L_ready
    global_load_dword v12, v16, s[12:13] offset:64 sc1
    s_waitcnt vmcnt(0)
    v_readfirstlane_b32 s39, v12
    s_cmp_eq_u32 s39, 0
    s_cbranch_scc1 L_spinf
L_ready:
    v_mov_b32 v23, s39
    v_mov_b32 v27, s39
    ds_write_b32 v16, v23 offset:3072
    s_mov_b32 s58, 1408
    s_add_u32 s60, s55, 1024
    v_mov_b32 v58, 3272
    s_mov_b32 s62, 8
    s_mov_b32 s59, 57
L_seq:
    s_mov_b64 exec, 1
    s_mov_b32 s54, 0x100000
L_sls:
    ds_read_b128 v[60:63], v16 offset:3952
    s_waitcnt lgkmcnt(0)
    v_max3_u32 v12, v60, v61, v62
    v_max_u32 v12, v12, v63
    s_nop 0
    v_readfirstlane_b32 s61, v12
    s_cmp_ge_u32 s61, s59
    s_cbranch_scc1 L_grab
    s_sub_u32 s54, s54, 1
    s_cbranch_scc0 L_sls
    s_mov_b32 s54, 0
L_grab:
    s_mov_b32 s53, 4096
    s_sub_u32 s62, s62, 1
    s_cbranch_scc1 L_got
    global_atomic_add v14, v18, v9, s[14:15] sc0
    s_waitcnt vmcnt(0)
    v_readfirstlane_b32 s53, v14
    s_min_u32 s53, s53, 4096
L_got:
    s_mul_i32 s53, s53, 8
    s_add_u32 s53, s53, s60
    v_mov_b32 v12, s53
    ds_write_b32 v58, v12
    v_add_u32 v58, 4, v58
    s_add_u32 s59, s59, 1
    s_cmp_lt_u32 s53, s58
    s_cbranch_scc1 L_sls
L_slsend:
    s_mov_b64 exec, -1
    s_cmp_eq_u32 s58, 4096
    s_cbranch_scc1 L_early
L_svround:
    s_cmp_lg_u32 s30, 7
    s_cbranch_scc1 L_sdump
    s_mov_b32 s58, 4096
    s_add_u32 s60, s55, 2816
    s_mov_b32 s62, 160
    v_add_u32 v18, 2048, v18
    v_mov_b32 v58, 3308
    s_lshl_b32 s59, s59, 1
    s_add_u32 s59, s59, 1
    s_branch L_seq
L_early:
    v_min_u32 v13, 96, v6
    ds_read_b128 v[80:83], v13 offset:3088
    ds_read_b128 v[84:87], v6 offset:12288
    ds_read_b128 v[88:91], v6 offset:13312
    ds_read_b128 v[92:95], v6 offset:14336
    ds_read_b128 v[96:99], v6 offset:15360
    ds_read_b128 v[100:103], v6 offset:16384
    ds_read_b128 v[104:107], v6 offset:17408
    ds_read_b128 v[108:111], v6 offset:18432
    s_mov_b64 exec, 127
    s_waitcnt lgkmcnt(7)
    global_store_dwordx4 v8, v[80:83], s[14:15] sc1
    s_mov_b64 exec, -1
    s_waitcnt lgkmcnt(6)
    global_store_dwordx4 v7, v[84:87], s[14:15] sc1
    v_add_u32 v7, 262144, v7
    s_waitcnt lgkmcnt(5)
    global_store_dwordx4 v7, v[88:91], s[14:15] sc1
    v_add_u32 v7, 262144, v7
    s_waitcnt lgkmcnt(4)
    global_store_dwordx4 v7, v[92:95], s[14:15] sc1
    v_add_u32 v7, 262144, v7
    s_waitcnt lgkmcnt(3)
    global_store_dwordx4 v7, v[96:99], s[14:15] sc1
    v_add_u32 v7, 262144, v7
    s_waitcnt lgkmcnt(2)
    global_store_dwordx4 v7, v[100:103], s[14:15] sc1
    v_add_u32 v7, 262144, v7
    s_waitcnt lgkmcnt(1)
    global_store_dwordx4 v7, v[104:107], s[14:15] sc1
    v_add_u32 v7, 262144, v7
    s_waitcnt lgkmcnt(0)
    global_store_dwordx4 v7, v[108:111], s[14:15] sc1
    v_add_u32 v7, 262144, v7
L_sdump:
    s_waitcnt lgkmcnt(0)
    s_barrier
    ds_read_b128 v[60:63], v54 offset:0
    ds_read_b128 v[64:67], v54 offset:1024
    ds_read_b128 v[68:71], v54 offset:2048
    ds_read_b128 v[72:75], v54 offset:3072
    ds_read_b32 v76, v28 offset:0
    ds_read_b32 v77, v28 offset:4
    ds_read_b32 v78, v28 offset:8
    ds_read_b32 v79, v28 offset:12
    v_add_u32 v54, s38, v54
    s_sub_u32 s38, 0, s38
    v_xor_b32 v28, 16, v28
    s_add_u32 s30, s30, 1
    s_waitcnt lgkmcnt(4)
    v_max_f32 v24, v63, v67
    v_max_f32 v24, v24, v71
    v_max_f32 v24, v24, v75
    v_sub_f32 v63, v63, v24
    v_sub_f32 v67, v67, v24
    v_sub_f32 v71, v71, v24
    v_sub_f32 v75, v75, v24
    v_exp_f32 v63, v63
    v_exp_f32 v67, v67
    v_exp_f32 v71, v71
    v_exp_f32 v75, v75
    s_waitcnt lgkmcnt(0)
    v_mul_f32 v20, v60, v63
    v_mul_f32 v21, v61, v63
    v_mul_f32 v22, v62, v63
    v_mul_f32 v25, v76, v63
    v_fma_f32 v20, v64, v67, v20
    v_fma_f32 v21, v65, v67, v21
    v_fma_f32 v22, v66, v67, v22
    v_fma_f32 v25, v77, v67, v25
    v_fma_f32 v20, v68, v71, v20
    v_fma_f32 v21, v69, v71, v21
    v_fma_f32 v22, v70, v71, v22
    v_fma_f32 v25, v78, v71, v25
    v_fma_f32 v20, v72, v75, v20
    v_fma_f32 v21, v73, v75, v21
    v_fma_f32 v22, v74, v75, v22
    v_fma_f32 v25, v79, v75, v25
    s_cmp_eq_u32 s30, 8
    s_cbranch_scc1 L_final
    ds_write_b128 v17, v[20:23]
    ds_write_b128 v19, v[24:27]
    v_add_u32 v17, 1024, v17
    v_add_u32 v19, 16, v19
    s_branch L_svround
L_final:
    global_store_dwordx4 v7, v[20:23], s[14:15] sc1
    s_mov_b64 exec, 128
    global_store_dwordx4 v8, v[24:27], s[14:15] sc1
L_done:
    s_endpgm
.section .rodata,"a"
.p2align 6
.amdhsa_kernel standalone__mha_softmax__decode_kernel
  .amdhsa_next_free_vgpr 124
  .amdhsa_next_free_sgpr 82
  .amdhsa_accum_offset 124
  .amdhsa_group_segment_fixed_size 0
  .amdhsa_kernarg_size 48
  .amdhsa_user_sgpr_count 2
  .amdhsa_user_sgpr_kernarg_segment_ptr 1
  .amdhsa_system_sgpr_workgroup_id_x 1
  .amdhsa_float_denorm_mode_32 3
.end_amdhsa_kernel
```
